```python
import torch

def _softmax(x, axis=-1):
    return torch.softmax(x, dim=axis)
def _gelu(x):
    return torch.nn.functional.gelu(x, approximate="tanh")
def _silu(x):
    return torch.nn.functional.silu(x)
def _sigmoid(x):
    return torch.sigmoid(x)
def _layernorm(x, axis=-1, eps=1e-5):
    m = x.mean(dim=axis, keepdim=True)
    v = x.var(dim=axis, keepdim=True, unbiased=False)
    return (x - m) / torch.sqrt(v + eps)
def _scatter_add(tgt, idx, src, axis=0):
    return tgt.clone().index_add_(axis, idx, src)
def _segment_sum(src, seg, n):
    out = torch.zeros((n,) + src.shape[1:], dtype=src.dtype)
    return out.index_add_(0, seg, src)
def _pad(x, pw):
    flat = tuple(v for pair in reversed(pw) for v in pair)
    return torch.nn.functional.pad(x, flat)

kernel_name = 'recurrent_scan__sliding_block_cached__mixer_token_mlp__decode'

def setup_inputs():

    _w = (lambda a: (lambda t: t.to(torch.bfloat16) if t.is_floating_point() else t)(torch.as_tensor(a)))
    def _A_setup():
        B, Sq, D = 1, 1, 576
        Hq, Hkv, Sk, Dh = 32, 16, 65536, 128
        assert Hq % Hkv == 0, (Hq, Hkv)
        return {
            "x": _w((lambda *s: torch.randn(*s, dtype=torch.bfloat16) * 0.05)(B, Sq, D)),
            "k_cache": _w((lambda *s: torch.randn(*s, dtype=torch.bfloat16) * 3.2)(B, Hkv, Sk, Dh)),
            "v_cache": _w((lambda *s: torch.randn(*s, dtype=torch.bfloat16) * 3.2)(B, Hkv, Sk, Dh)),
            "wq": _w((lambda *s: torch.randn(*s, dtype=torch.bfloat16) * 3.2)(D, Hq * Dh) * (D ** -0.5)),
            "wo": _w((lambda *s: torch.randn(*s, dtype=torch.bfloat16) * 3.2)(Hq * Dh, D) * ((Hq * Dh) ** -0.5)),
        }
    _A_in = _A_setup()

    def _B_setup():
        B, S, D, F = 1, 1, 576, 4608
        return {
            "x": _w((lambda *s: torch.randn(*s, dtype=torch.bfloat16) * 0.05)(B, S, D)),
            "w1": _w((lambda *s: torch.randn(*s, dtype=torch.bfloat16) * 3.2)(S, F) * (S ** -0.5)),
            "b1": _w((lambda *s: torch.randn(*s, dtype=torch.bfloat16) * 3.2)(F) * 0.02),
            "w2": _w((lambda *s: torch.randn(*s, dtype=torch.bfloat16) * 0.4)(F, S) * (F ** -0.5)),
            "b2": _w((lambda *s: torch.randn(*s, dtype=torch.bfloat16) * 0.4)(S) * 0.02),
        }
    _B_in = _B_setup()

    return {
        "A_x": _A_in["x"],
        "A_k_cache": _A_in["k_cache"],
        "A_v_cache": _A_in["v_cache"],
        "A_wq": _A_in["wq"],
        "A_wo": _A_in["wo"],
        "B_x": _B_in["x"],
        "B_w1": _B_in["w1"],
        "B_b1": _B_in["b1"],
        "B_w2": _B_in["w2"],
        "B_b2": _B_in["b2"],
    }

def reference(A_x, A_k_cache, A_v_cache, A_wq, A_wo, B_x, B_w1, B_b1, B_w2, B_b2):
    def _A_ref(x, k_cache, v_cache, wq, wo):
        B, Sq, D = x.shape
        Hq, Dh = 32, 128
        Hkv, Sk = k_cache.shape[1], k_cache.shape[2]
        W = min(4096, max(256, Sk // 4))
        rep = Hq // Hkv
        q = (lambda x, *d: x.permute(*d))((x @ wq).reshape(B, Sq, Hq, Dh), 0, 2, 1, 3)
        k = (lambda x, n, axis: torch.repeat_interleave(x, n, dim=axis))(k_cache[:, :, Sk - W:, :], rep, axis=1)
        v = (lambda x, n, axis: torch.repeat_interleave(x, n, dim=axis))(v_cache[:, :, Sk - W:, :], rep, axis=1)
        scores = torch.einsum("bhqd,bhkd->bhqk", q, k) * (Dh ** -0.5)
        p = _softmax(scores, axis=-1)
        o = torch.einsum("bhqk,bhkd->bhqd", p, v)
        return (lambda x, *d: x.permute(*d))(o, 0, 2, 1, 3).reshape(B, Sq, Hq * Dh) @ wo

    def _B_ref(x, w1, b1, w2, b2):
        B, S, D = x.shape
        h = _layernorm(x, axis=-1)
        u = torch.einsum("bsd,sf->bdf", h, w1) + b1
        u = _gelu(u)
        y = torch.einsum("bdf,fs->bds", u, w2) + b2
        return (lambda x, *d: x.permute(*d))(y, 0, 2, 1)

    x = A_x
    xn = _layernorm(x, axis=-1)
    s = _A_ref(xn, A_k_cache, A_v_cache, A_wq, A_wo)
    g = _silu(_B_ref(xn, B_w1, B_b1, B_w2, B_b2))
    return x + s * g
```

```asm
; @launch grid=(256,1,1) block=(512,1,1) lds=126976
.amdgcn_target "amdgcn-amd-amdhsa--gfx950"
.text
.globl recurrent_scan__sliding_block_cached__mixer_token_mlp__decode_kernel
.p2align 8
.type recurrent_scan__sliding_block_cached__mixer_token_mlp__decode_kernel,@function
recurrent_scan__sliding_block_cached__mixer_token_mlp__decode_kernel:
    s_cmp_ge_u32 s2, 256
    s_cbranch_scc1 L_end
    v_lshrrev_b32 v1, 6, v0
    v_and_b32 v0, 63, v0
    v_readfirstlane_b32 s3, v1
    v_mov_b32 v3, 0
    v_lshlrev_b32 v4, 2, v0
    s_cmp_lg_u32 s3, 6
    s_cbranch_scc1 L_noinit
    ds_write_b32 v4, v3
    ds_write_b32 v4, v3 offset:3392
    s_waitcnt lgkmcnt(0)
L_noinit:
    s_load_dwordx16 s[8:23], s[0:1], 0
    s_load_dwordx8 s[24:31], s[0:1], 64
    s_load_dwordx2 s[32:33], s[0:1], 96
    s_and_b32 s4, s2, 7
    s_lshl_b32 s4, s4, 1
    s_lshr_b32 s5, s2, 7
    s_or_b32 s4, s4, s5
    s_lshr_b32 s5, s2, 3
    s_and_b32 s5, s5, 15
    s_lshr_b32 s6, s5, 3
    s_lshl_b32 s7, s4, 1
    s_add_u32 s6, s6, s7
    s_and_b32 s7, s5, 7
    v_lshrrev_b32 v1, 4, v0
    v_and_b32 v2, 15, v0
    s_barrier
    s_cmp_ge_u32 s3, 4
    s_cbranch_scc1 L_B
    s_lshl_b32 s60, s4, 24
    s_lshl_b32 s61, s5, 16
    s_add_u32 s60, s60, s61
    s_add_u32 s60, s60, 15728640
    s_sub_u32 s56, 3, s3
    s_and_b32 s57, s56, 1
    s_lshl_b32 s57, s57, 2
    v_lshrrev_b32 v10, 3, v0
    v_lshlrev_b32 v10, 13, v10
    v_and_b32 v11, 7, v0
    v_bfe_u32 v12, v0, 4, 1
    v_lshlrev_b32 v12, 1, v12
    v_xor_b32 v11, v11, v12
    v_xor_b32 v11, s57, v11
    v_lshl_add_u32 v13, v11, 4, v10
    s_lshl_b32 s58, s56, 16
    s_lshl_b32 s59, s56, 10
    s_add_u32 m0, s59, 15360
    s_lshl_b32 s56, s4, 9
    s_and_b32 s57, s5, 3
    s_lshl_b32 s57, s57, 7
    s_add_u32 s56, s56, s57
    s_lshr_b32 s57, s5, 2
    s_mul_i32 s57, s57, 1179648
    s_add_u32 s56, s56, s57
    s_mov_b32 s50, 1171584
    s_mov_b32 s51, 0x20000
    s_mov_b32 s42, 65536
    s_mov_b32 s43, 0x20000
    s_mov_b32 s46, 65536
    s_mov_b32 s47, 0x20000
    s_lshl_b32 s61, s5, 2
    s_add_u32 s61, s61, s3
    s_lshl_b32 s61, s61, 10
    s_lshl_b32 s62, s3, 14
    s_add_u32 s62, s62, 61440
    v_lshlrev_b32 v3, 8, v1
    v_add_u32 v4, 0, v1
    v_xor_b32 v4, v4, v2
    v_lshl_add_u32 v4, v4, 4, v3
    v_add_u32 v5, 4, v1
    v_xor_b32 v5, v5, v2
    v_lshl_add_u32 v5, v5, 4, v3
    v_add_u32 v6, 8, v1
    v_xor_b32 v6, v6, v2
    v_lshl_add_u32 v6, v6, 4, v3
    v_add_u32 v7, 12, v1
    v_xor_b32 v7, v7, v2
    v_lshl_add_u32 v7, v7, 4, v3
    v_lshlrev_b32 v8, 4, v0
    s_waitcnt lgkmcnt(0)
    s_mov_b32 s30, s3
    s_add_u32 s48, s14, s56
    s_addc_u32 s49, s15, 0
    s_add_u32 s40, s10, s60
    s_addc_u32 s41, s11, 0
    s_add_u32 s44, s12, s60
    s_addc_u32 s45, s13, 0
    buffer_load_dwordx4 v13, s[48:51], s58 offen nt lds
    s_add_u32 m0, m0, 4096
    s_add_u32 s58, s58, 262144
    buffer_load_dwordx4 v13, s[48:51], s58 offen nt lds
    s_add_u32 m0, m0, 4096
    s_add_u32 s58, s58, 262144
    buffer_load_dwordx4 v13, s[48:51], s58 offen nt lds
    s_add_u32 m0, m0, 4096
    s_add_u32 s58, s58, 262144
    buffer_load_dwordx4 v13, s[48:51], s58 offen nt lds
    s_add_u32 m0, m0, 4096
    s_add_u32 s58, s58, 262144
    buffer_load_dwordx4 v13, s[48:51], s58 offen nt lds
    s_mov_b32 m0, s62
    s_add_u32 s64, s61, 0
    s_and_b32 s64, s64, 0xffff
    buffer_load_dwordx4 v4, s[40:43], s64 offen nt lds
    s_add_u32 m0, m0, 1024
    s_add_u32 s65, s61, 4096
    s_and_b32 s65, s65, 0xffff
    buffer_load_dwordx4 v5, s[40:43], s65 offen nt lds
    s_add_u32 m0, m0, 1024
    s_add_u32 s66, s61, 8192
    s_and_b32 s66, s66, 0xffff
    buffer_load_dwordx4 v6, s[40:43], s66 offen nt lds
    s_add_u32 m0, m0, 1024
    v_xor_b32 v3, v1, v2
    v_lshlrev_b32 v9, 8, v2
    v_add_u32 v9, s62, v9
    s_mov_b32 s36, s32
    s_mov_b32 s37, s33
    s_mov_b32 s38, 2097152
    s_mov_b32 s39, 0x20000
    v_xor_b32 v14, 0, v3
    v_lshl_add_u32 v14, v14, 4, v9
    v_xor_b32 v15, 4, v3
    v_lshl_add_u32 v15, v15, 4, v9
    v_xor_b32 v16, 8, v3
    v_lshl_add_u32 v16, v16, 4, v9
    v_xor_b32 v17, 12, v3
    v_lshl_add_u32 v17, v17, 4, v9
    v_and_b32 v9, 1, v2
    v_lshlrev_b32 v18, 8, v9
    v_lshl_add_u32 v18, v1, 4, v18
    v_lshlrev_b32 v10, 7, v9
    v_lshl_add_u32 v10, v1, 4, v10
    s_lshl_b32 s56, s3, 8
    s_add_u32 s56, s56, 3648
    v_add_u32 v10, s56, v10
    v_mov_b32 v9, 3392
    v_and_b32 v3, 14, v2
    v_cmp_eq_u32 vcc, 0, v3
    s_nop 1
    v_cndmask_b32 v19, v9, v10, vcc
    v_cmp_eq_u32 vcc, 4, v3
    s_nop 1
    v_cndmask_b32 v20, v9, v10, vcc
    v_cmp_eq_u32 vcc, 8, v3
    s_nop 1
    v_cndmask_b32 v21, v9, v10, vcc
    v_cmp_eq_u32 vcc, 12, v3
    s_nop 1
    v_cndmask_b32 v22, v9, v10, vcc
    v_lshrrev_b32 v23, 5, v0
    v_lshlrev_b32 v23, 6, v23
    v_and_b32 v3, 3, v0
    v_lshl_add_u32 v23, v3, 4, v23
    v_bfe_u32 v3, v0, 2, 3
    v_lshl_add_u32 v23, v3, 1, v23
    v_add_u32 v23, s56, v23
    v_cmp_eq_u32 s[18:19], 1, v1
    v_cmp_eq_u32 s[20:21], 2, v1
    v_cmp_eq_u32 s[22:23], 3, v1
    s_mov_b32 s24, 1035273459
    s_mov_b32 s25, 1069066811
    s_mov_b32 s26, 0x05040100
    s_mov_b32 s27, 0x07060302
    v_lshlrev_b32 v24, 5, v2
    v_lshl_add_u32 v24, v1, 2, v24
    s_lshl_b32 s56, s3, 10
    v_add_u32 v24, s56, v24
    s_lshl_b32 s56, s3, 2
    v_mov_b32 v25, s56
    v_mov_b32 v26, 1
    s_lshl_b32 s56, s3, 9
    v_lshlrev_b32 v27, 3, v0
    v_add_u32 v27, s56, v27
    s_lshl_b32 s56, s4, 1
    s_add_u32 s56, s56, s3
    s_lshl_b32 s56, s56, 12
    s_lshl_b32 s57, s5, 8
    s_add_u32 s56, s56, s57
    s_add_u32 s56, s56, 65536
    v_lshlrev_b32 v28, 2, v0
    v_add_u32 v28, s56, v28
    v_mov_b32 v29, 0
    s_lshl_b32 s56, s3, 4
    v_mov_b32 v30, s56
    s_waitcnt vmcnt(3)
    ds_write_b32 v25, v26 offset:224
    s_add_u32 s67, s61, 12288
    s_and_b32 s67, s67, 0xffff
    buffer_load_dwordx4 v7, s[40:43], s67 offen nt lds
    s_add_u32 m0, m0, 1024
    s_waitcnt vmcnt(3)
    s_add_u32 s68, s61, 16384
    s_and_b32 s68, s68, 0xffff
    buffer_load_dwordx4 v4, s[40:43], s68 offen nt lds
    s_add_u32 m0, m0, 1024
    s_waitcnt vmcnt(3)
    s_add_u32 s69, s61, 20480
    s_and_b32 s69, s69, 0xffff
    buffer_load_dwordx4 v5, s[40:43], s69 offen nt lds
    s_add_u32 m0, m0, 1024
    s_waitcnt vmcnt(3)
    s_add_u32 s70, s61, 24576
    s_and_b32 s70, s70, 0xffff
    buffer_load_dwordx4 v6, s[40:43], s70 offen nt lds
    s_add_u32 m0, m0, 1024
    s_waitcnt vmcnt(3)
    s_add_u32 s71, s61, 28672
    s_and_b32 s71, s71, 0xffff
    buffer_load_dwordx4 v7, s[40:43], s71 offen nt lds
    s_add_u32 m0, m0, 1024
    s_waitcnt vmcnt(3)
    s_add_u32 s72, s61, 32768
    s_and_b32 s72, s72, 0xffff
    buffer_load_dwordx4 v4, s[40:43], s72 offen nt lds
    s_add_u32 m0, m0, 1024
    s_waitcnt vmcnt(3)
    s_add_u32 s73, s61, 36864
    s_and_b32 s73, s73, 0xffff
    buffer_load_dwordx4 v5, s[40:43], s73 offen nt lds
    s_add_u32 m0, m0, 1024
    s_waitcnt vmcnt(3)
    s_add_u32 s74, s61, 40960
    s_and_b32 s74, s74, 0xffff
    buffer_load_dwordx4 v6, s[40:43], s74 offen nt lds
    s_add_u32 m0, m0, 1024
    s_waitcnt vmcnt(3)
    s_add_u32 s75, s61, 45056
    s_and_b32 s75, s75, 0xffff
    buffer_load_dwordx4 v7, s[40:43], s75 offen nt lds
    s_add_u32 m0, m0, 1024
    s_waitcnt vmcnt(3)
    s_add_u32 s76, s61, 49152
    s_and_b32 s76, s76, 0xffff
    buffer_load_dwordx4 v4, s[40:43], s76 offen nt lds
    s_add_u32 m0, m0, 1024
    s_add_u32 s77, s61, 53248
    s_and_b32 s77, s77, 0xffff
    buffer_load_dwordx4 v5, s[40:43], s77 offen nt lds
    s_add_u32 m0, m0, 1024
    s_add_u32 s78, s61, 57344
    s_and_b32 s78, s78, 0xffff
    buffer_load_dwordx4 v6, s[40:43], s78 offen nt lds
    s_add_u32 m0, m0, 1024
    s_add_u32 s79, s61, 61440
    s_and_b32 s79, s79, 0xffff
    buffer_load_dwordx4 v7, s[40:43], s79 offen nt lds
    buffer_load_dwordx4 v[96:99], v8, s[44:47], s64 offen nt
    buffer_load_dwordx4 v[100:103], v8, s[44:47], s65 offen nt
    buffer_load_dwordx4 v[104:107], v8, s[44:47], s66 offen nt
    buffer_load_dwordx4 v[108:111], v8, s[44:47], s67 offen nt
    buffer_load_dwordx4 v[112:115], v8, s[44:47], s68 offen nt
    buffer_load_dwordx4 v[116:119], v8, s[44:47], s69 offen nt
    buffer_load_dwordx4 v[120:123], v8, s[44:47], s70 offen nt
    buffer_load_dwordx4 v[124:127], v8, s[44:47], s71 offen nt
    s_waitcnt vmcnt(8)
    ds_read_b128 v[32:35], v14 offset:0
    ds_read_b128 v[36:39], v15 offset:0
    ds_read_b128 v[40:43], v16 offset:0
    ds_read_b128 v[44:47], v17 offset:0
    ds_read_b128 v[48:51], v14 offset:4096
    ds_read_b128 v[52:55], v15 offset:4096
    ds_read_b128 v[56:59], v16 offset:4096
    ds_read_b128 v[60:63], v17 offset:4096
    ds_read_b128 v[64:67], v14 offset:8192
    ds_read_b128 v[68:71], v15 offset:8192
    ds_read_b128 v[72:75], v16 offset:8192
    ds_read_b128 v[76:79], v17 offset:8192
    ds_read_b128 v[80:83], v14 offset:12288
    ds_read_b128 v[84:87], v15 offset:12288
    ds_read_b128 v[88:91], v16 offset:12288
    ds_read_b128 v[92:95], v17 offset:12288
    buffer_load_dwordx4 v[128:131], v8, s[44:47], s72 offen nt
    buffer_load_dwordx4 v[132:135], v8, s[44:47], s73 offen nt
    buffer_load_dwordx4 v[136:139], v8, s[44:47], s74 offen nt
    buffer_load_dwordx4 v[140:143], v8, s[44:47], s75 offen nt
    buffer_load_dwordx4 v[144:147], v8, s[44:47], s76 offen nt
    buffer_load_dwordx4 v[148:151], v8, s[44:47], s77 offen nt
    buffer_load_dwordx4 v[152:155], v8, s[44:47], s78 offen nt
    buffer_load_dwordx4 v[156:159], v8, s[44:47], s79 offen nt
    v_mov_b32 v3, 0
    s_mov_b32 s35, 0
    s_nop 0
SP_1:
    ds_read_b128 v[160:163], v3 offset:0
    s_add_u32 s35, s35, 1
    s_cmp_gt_u32 s35, 1048576
    s_cbranch_scc1 L_end
    s_waitcnt lgkmcnt(0)
    v_and_b32 v160, v160, v161
    v_and_b32 v162, v162, v163
    v_and_b32 v160, v160, v162
    v_cmp_ne_u32 vcc, 1, v160
    s_cbranch_vccnz SP_1
    ds_read_b128 v[160:163], v18 offset:2880
    ds_read_b128 v[164:167], v18 offset:2944
    ds_read_b128 v[168:171], v18 offset:3008
    ds_read_b128 v[172:175], v18 offset:3072
    s_waitcnt vmcnt(8)
    s_waitcnt lgkmcnt(3)
    v_mfma_f32_16x16x32_bf16 v[176:179], v[160:163], v[32:35], 0
    v_perm_b32 v224, v100, v96, s26
    v_perm_b32 v228, v100, v96, s27
    v_mfma_f32_16x16x32_bf16 v[180:183], v[160:163], v[48:51], 0
    v_perm_b32 v232, v101, v97, s26
    v_perm_b32 v236, v101, v97, s27
    v_mfma_f32_16x16x32_bf16 v[184:187], v[160:163], v[64:67], 0
    v_perm_b32 v240, v102, v98, s26
    v_perm_b32 v244, v102, v98, s27
    v_mfma_f32_16x16x32_bf16 v[188:191], v[160:163], v[80:83], 0
    v_perm_b32 v248, v103, v99, s26
    v_perm_b32 v252, v103, v99, s27
    s_waitcnt lgkmcnt(2)
    v_mfma_f32_16x16x32_bf16 v[176:179], v[164:167], v[36:39], v[176:179]
    v_perm_b32 v225, v108, v104, s26
    v_perm_b32 v229, v108, v104, s27
    v_mfma_f32_16x16x32_bf16 v[180:183], v[164:167], v[52:55], v[180:183]
    v_perm_b32 v233, v109, v105, s26
    v_perm_b32 v237, v109, v105, s27
    v_mfma_f32_16x16x32_bf16 v[184:187], v[164:167], v[68:71], v[184:187]
    v_perm_b32 v241, v110, v106, s26
    v_perm_b32 v245, v110, v106, s27
    v_mfma_f32_16x16x32_bf16 v[188:191], v[164:167], v[84:87], v[188:191]
    v_perm_b32 v249, v111, v107, s26
    v_perm_b32 v253, v111, v107, s27
    s_waitcnt lgkmcnt(1)
    v_mfma_f32_16x16x32_bf16 v[176:179], v[168:171], v[40:43], v[176:179]
    v_perm_b32 v226, v116, v112, s26
    v_perm_b32 v230, v116, v112, s27
    v_mfma_f32_16x16x32_bf16 v[180:183], v[168:171], v[56:59], v[180:183]
    v_perm_b32 v234, v117, v113, s26
    v_perm_b32 v238, v117, v113, s27
    v_mfma_f32_16x16x32_bf16 v[184:187], v[168:171], v[72:75], v[184:187]
    v_perm_b32 v242, v118, v114, s26
    v_perm_b32 v246, v118, v114, s27
    v_mfma_f32_16x16x32_bf16 v[188:191], v[168:171], v[88:91], v[188:191]
    v_perm_b32 v250, v119, v115, s26
    v_perm_b32 v254, v119, v115, s27
    s_waitcnt lgkmcnt(0)
    v_mfma_f32_16x16x32_bf16 v[176:179], v[172:175], v[44:47], v[176:179]
    v_perm_b32 v227, v124, v120, s26
    v_perm_b32 v231, v124, v120, s27
    v_mfma_f32_16x16x32_bf16 v[180:183], v[172:175], v[60:63], v[180:183]
    v_perm_b32 v235, v125, v121, s26
    v_perm_b32 v239, v125, v121, s27
    v_mfma_f32_16x16x32_bf16 v[184:187], v[172:175], v[76:79], v[184:187]
    v_perm_b32 v243, v126, v122, s26
    v_perm_b32 v247, v126, v122, s27
    v_mfma_f32_16x16x32_bf16 v[188:191], v[172:175], v[92:95], v[188:191]
    v_perm_b32 v251, v127, v123, s26
    v_perm_b32 v255, v127, v123, s27
    v_cndmask_b32 v160, v176, v180, s[18:19]
    v_cndmask_b32 v161, v177, v181, s[18:19]
    s_nop 0
    v_cndmask_b32 v160, v160, v184, s[20:21]
    v_cndmask_b32 v161, v161, v185, s[20:21]
    s_nop 0
    v_cndmask_b32 v160, v160, v188, s[22:23]
    v_cndmask_b32 v161, v161, v189, s[22:23]
    v_cvt_pk_bf16_f32 v162, v160, v161
    v_lshlrev_b32 v160, 16, v162
    v_and_b32 v161, 0xffff0000, v162
    v_mul_f32 v160, s24, v160
    v_mul_f32 v161, s24, v161
    v_cvt_pk_bf16_f32 v162, v160, v161
    v_lshlrev_b32 v160, 16, v162
    v_and_b32 v161, 0xffff0000, v162
    v_mov_b32 v164, v160
    v_mov_b32 v165, v161
    s_nop 0
    v_max_f32_dpp v164, v164, v164 row_ror:8 row_mask:0xf bank_mask:0xf
    v_max_f32_dpp v165, v165, v165 row_ror:8 row_mask:0xf bank_mask:0xf
    s_nop 0
    v_max_f32_dpp v164, v164, v164 row_ror:4 row_mask:0xf bank_mask:0xf
    v_max_f32_dpp v165, v165, v165 row_ror:4 row_mask:0xf bank_mask:0xf
    s_nop 0
    v_max_f32_dpp v164, v164, v164 row_ror:2 row_mask:0xf bank_mask:0xf
    v_max_f32_dpp v165, v165, v165 row_ror:2 row_mask:0xf bank_mask:0xf
    s_nop 0
    v_max_f32_dpp v164, v164, v164 row_ror:1 row_mask:0xf bank_mask:0xf
    v_max_f32_dpp v165, v165, v165 row_ror:1 row_mask:0xf bank_mask:0xf
    v_mov_b32 v162, v164
    v_mov_b32 v163, v165
    s_nop 0
    v_permlane16_swap_b32 v164, v162
    v_permlane16_swap_b32 v165, v163
    v_max_f32 v164, v164, v162
    v_max_f32 v165, v165, v163
    v_mov_b32 v162, v164
    v_mov_b32 v163, v165
    s_nop 0
    v_permlane32_swap_b32 v164, v162
    v_permlane32_swap_b32 v165, v163
    v_max_f32 v164, v164, v162
    v_max_f32 v165, v165, v163
    v_sub_f32 v160, v160, v164
    v_sub_f32 v161, v161, v165
    v_mul_f32 v160, s25, v160
    v_mul_f32 v161, s25, v161
    v_exp_f32 v160, v160
    v_exp_f32 v161, v161
    v_mov_b32 v166, 1
    v_mov_b32 v167, 1
    v_cvt_pk_bf16_f32 v162, v160, v161
    ds_write_b16 v23, v162
    ds_write_b16_d16_hi v23, v162 offset:128
    ds_write_b128 v30, v[164:167] offset:32
    s_waitcnt lgkmcnt(1)
    ds_read_b128 v[192:195], v19 offset:0
    ds_read_b128 v[196:199], v20 offset:0
    ds_read_b128 v[200:203], v21 offset:0
    ds_read_b128 v[204:207], v22 offset:0
    ds_read_b128 v[208:211], v19 offset:64
    ds_read_b128 v[212:215], v20 offset:64
    ds_read_b128 v[216:219], v21 offset:64
    ds_read_b128 v[220:223], v22 offset:64
    v_add_f32_dpp v160, v160, v160 row_ror:8 row_mask:0xf bank_mask:0xf
    v_add_f32_dpp v161, v161, v161 row_ror:8 row_mask:0xf bank_mask:0xf
    s_nop 0
    v_add_f32_dpp v160, v160, v160 row_ror:4 row_mask:0xf bank_mask:0xf
    v_add_f32_dpp v161, v161, v161 row_ror:4 row_mask:0xf bank_mask:0xf
    s_nop 0
    v_add_f32_dpp v160, v160, v160 row_ror:2 row_mask:0xf bank_mask:0xf
    v_add_f32_dpp v161, v161, v161 row_ror:2 row_mask:0xf bank_mask:0xf
    s_nop 0
    v_add_f32_dpp v160, v160, v160 row_ror:1 row_mask:0xf bank_mask:0xf
    v_add_f32_dpp v161, v161, v161 row_ror:1 row_mask:0xf bank_mask:0xf
    v_mov_b32 v162, v160
    v_mov_b32 v163, v161
    s_nop 0
    v_permlane16_swap_b32 v160, v162
    v_permlane16_swap_b32 v161, v163
    v_add_f32 v160, v160, v162
    v_add_f32 v161, v161, v163
    v_mov_b32 v162, v160
    v_mov_b32 v163, v161
    s_nop 0
    v_permlane32_swap_b32 v160, v162
    v_permlane32_swap_b32 v161, v163
    v_add_f32 v160, v160, v162
    v_add_f32 v161, v161, v163
    v_mov_b32 v176, v160
    v_mov_b32 v177, v161
    v_mov_b32 v178, 1
    v_mov_b32 v179, 1
    ds_write_b128 v30, v[176:179] offset:96
    s_waitcnt lgkmcnt(1)
    v_mfma_f32_16x16x32_bf16 v[168:171], v[192:195], v[224:227], 0
    v_mfma_f32_16x16x32_bf16 v[172:175], v[192:195], v[240:243], 0
    v_mfma_f32_16x16x32_bf16 v[168:171], v[196:199], v[228:231], v[168:171]
    v_mfma_f32_16x16x32_bf16 v[172:175], v[196:199], v[244:247], v[172:175]
    v_mfma_f32_16x16x32_bf16 v[168:171], v[200:203], v[232:235], v[168:171]
    v_mfma_f32_16x16x32_bf16 v[172:175], v[200:203], v[248:251], v[172:175]
    v_mfma_f32_16x16x32_bf16 v[168:171], v[204:207], v[236:239], v[168:171]
    v_mfma_f32_16x16x32_bf16 v[172:175], v[204:207], v[252:255], v[172:175]
    ds_write_b32 v25, v26 offset:240
    ds_read_b128 v[176:179], v29 offset:32
    ds_read_b128 v[180:183], v29 offset:48
    ds_read_b128 v[184:187], v29 offset:64
    ds_read_b128 v[188:191], v29 offset:80
    s_waitcnt vmcnt(6)
    v_perm_b32 v32, v132, v128, s26
    v_perm_b32 v36, v132, v128, s27
    v_perm_b32 v40, v133, v129, s26
    v_perm_b32 v44, v133, v129, s27
    v_perm_b32 v48, v134, v130, s26
    v_perm_b32 v52, v134, v130, s27
    v_perm_b32 v56, v135, v131, s26
    v_perm_b32 v60, v135, v131, s27
    s_mov_b32 s35, 0
    s_nop 0
    s_branch MXC_3
MXR_2:
    ds_read_b128 v[176:179], v29 offset:32
    ds_read_b128 v[180:183], v29 offset:48
    ds_read_b128 v[184:187], v29 offset:64
    ds_read_b128 v[188:191], v29 offset:80
MXC_3:
    s_add_u32 s35, s35, 1
    s_cmp_gt_u32 s35, 1048576
    s_cbranch_scc1 L_end
    s_waitcnt lgkmcnt(0)
    v_and_b32 v162, v178, v182
    v_and_b32 v163, v186, v190
    v_and_b32 v162, v162, v163
    v_cmp_ne_u32 vcc, 1, v162
    s_cbranch_vccnz MXR_2
    v_max3_f32 v176, v176, v180, v184
    v_max3_f32 v177, v177, v181, v185
    v_max_f32 v176, v176, v188
    v_max_f32 v177, v177, v189
    v_sub_f32 v164, v164, v176
    v_sub_f32 v165, v165, v177
    v_mul_f32 v164, s25, v164
    v_mul_f32 v165, s25, v165
    v_exp_f32 v164, v164
    v_exp_f32 v165, v165
    s_waitcnt vmcnt(4)
    v_perm_b32 v33, v140, v136, s26
    v_perm_b32 v37, v140, v136, s27
    v_perm_b32 v41, v141, v137, s26
    v_perm_b32 v45, v141, v137, s27
    v_perm_b32 v49, v142, v138, s26
    v_perm_b32 v53, v142, v138, s27
    v_perm_b32 v57, v143, v139, s26
    v_perm_b32 v61, v143, v139, s27
    s_waitcnt vmcnt(2)
    v_perm_b32 v34, v148, v144, s26
    v_perm_b32 v38, v148, v144, s27
    v_perm_b32 v42, v149, v145, s26
    v_perm_b32 v46, v149, v145, s27
    v_perm_b32 v50, v150, v146, s26
    v_perm_b32 v54, v150, v146, s27
    v_perm_b32 v58, v151, v147, s26
    v_perm_b32 v62, v151, v147, s27
    s_waitcnt vmcnt(0)
    v_perm_b32 v35, v156, v152, s26
    v_perm_b32 v39, v156, v152, s27
    v_perm_b32 v43, v157, v153, s26
    v_perm_b32 v47, v157, v153, s27
    v_perm_b32 v51, v158, v154, s26
    v_perm_b32 v55, v158, v154, s27
    v_perm_b32 v59, v159, v155, s26
    v_perm_b32 v63, v159, v155, s27
    v_mfma_f32_16x16x32_bf16 v[168:171], v[208:211], v[32:35], v[168:171]
    v_mfma_f32_16x16x32_bf16 v[172:175], v[208:211], v[48:51], v[172:175]
    v_mfma_f32_16x16x32_bf16 v[168:171], v[212:215], v[36:39], v[168:171]
    v_mfma_f32_16x16x32_bf16 v[172:175], v[212:215], v[52:55], v[172:175]
    v_mfma_f32_16x16x32_bf16 v[168:171], v[216:219], v[40:43], v[168:171]
    v_mfma_f32_16x16x32_bf16 v[172:175], v[216:219], v[56:59], v[172:175]
    v_mfma_f32_16x16x32_bf16 v[168:171], v[220:223], v[44:47], v[168:171]
    v_mfma_f32_16x16x32_bf16 v[172:175], v[220:223], v[60:63], v[172:175]
    s_nop 6
    v_mul_f32 v168, v168, v164
    v_mul_f32 v169, v169, v165
    v_mul_f32 v172, v172, v164
    v_mul_f32 v173, v173, v165
    ds_write_b32 v24, v168 offset:4672
    ds_write_b32 v24, v169 offset:5184
    ds_write_b32 v24, v172 offset:4688
    ds_write_b32 v24, v173 offset:5200
    ds_write_b32 v25, v26 offset:160
    s_cmp_eq_u32 s3, 3
    s_cbranch_scc1 L_A3
    s_cmp_eq_u32 s3, 2
    s_cbranch_scc1 L_A2
    s_mov_b32 s35, 0
SP_4:
    ds_read_b128 v[32:35], v29 offset:160
    ds_read_b128 v[36:39], v29 offset:176
    ds_read_b64 v[40:41], v27 offset:4672
    ds_read_b64 v[42:43], v27 offset:5696
    ds_read_b64 v[44:45], v27 offset:6720
    ds_read_b64 v[46:47], v27 offset:7744
    s_add_u32 s35, s35, 1
    s_cmp_gt_u32 s35, 1048576
    s_cbranch_scc1 L_end
    s_waitcnt lgkmcnt(0)
    v_and_b32 v32, v32, v33
    v_and_b32 v34, v34, v35
    v_and_b32 v36, v36, v37
    v_and_b32 v38, v38, v39
    v_add_f32 v40, v40, v42
    v_add_f32 v41, v41, v43
    v_and_b32 v32, v32, v34
    v_and_b32 v36, v36, v38
    v_add_f32 v44, v44, v46
    v_add_f32 v45, v45, v47
    v_and_b32 v32, v32, v36
    v_cmp_ne_u32 vcc, 1, v32
    v_add_f32 v40, v40, v44
    v_add_f32 v41, v41, v45
    s_cbranch_vccnz SP_4
    v_cvt_pk_bf16_f32 v40, v40, v41
    v_min_u32 v40, -2, v40
    s_mov_b32 s56, 458752
    buffer_store_dword v40, v28, s[36:39], s56 offen
    buffer_store_dword v40, v28, s[36:39], 0 offen sc1
L_Aend:
    s_endpgm
L_A2:
    s_lshl_b32 s56, s4, 1
    s_lshr_b32 s57, s5, 3
    s_add_u32 s56, s56, s57
    s_lshl_b32 s56, s56, 10
    s_add_u32 s56, s56, 458752
    v_lshlrev_b32 v11, 6, v2
    v_add_u32 v11, s56, v11
    v_mov_b32 v3, 0
    s_mov_b32 s35, 0
    s_nop 0
SP_5:
    ds_read_b128 v[16:19], v3 offset:16
    s_add_u32 s35, s35, 1
    s_cmp_gt_u32 s35, 1048576
    s_cbranch_scc1 L_end
    s_waitcnt lgkmcnt(0)
    v_and_b32 v17, v17, v18
    v_cmp_ne_u32 vcc, 1, v17
    s_cbranch_vccnz SP_5
    s_mov_b32 s35, 0
    s_nop 2
SP_6:
    buffer_load_dwordx2 v[14:15], v11, s[36:39], 0 offen sc1
    s_add_u32 s35, s35, 1
    s_cmp_gt_u32 s35, 131072
    s_cbranch_scc1 L_end
    s_waitcnt vmcnt(0)
    v_max_u32 v16, v14, v15
    v_cmp_eq_u32 vcc, -1, v16
    s_cbranch_vccnz SP_6
    v_mov_b32 v16, v14
    s_nop 1
    v_max_f32_dpp v16, v16, v16 row_ror:8 row_mask:0xf bank_mask:0xf
    s_nop 1
    v_max_f32_dpp v16, v16, v16 row_ror:4 row_mask:0xf bank_mask:0xf
    s_nop 1
    v_max_f32_dpp v16, v16, v16 row_ror:2 row_mask:0xf bank_mask:0xf
    s_nop 1
    v_max_f32_dpp v16, v16, v16 row_ror:1 row_mask:0xf bank_mask:0xf
    v_sub_f32 v16, v14, v16
    v_mul_f32 v16, 1069066811, v16
    v_exp_f32 v16, v16
    s_nop 0
    v_mul_f32 v17, v16, v15
    s_nop 1
    v_add_f32_dpp v17, v17, v17 row_ror:8 row_mask:0xf bank_mask:0xf
    s_nop 1
    v_add_f32_dpp v17, v17, v17 row_ror:4 row_mask:0xf bank_mask:0xf
    s_nop 1
    v_add_f32_dpp v17, v17, v17 row_ror:2 row_mask:0xf bank_mask:0xf
    s_nop 1
    v_add_f32_dpp v17, v17, v17 row_ror:1 row_mask:0xf bank_mask:0xf
    v_rcp_f32 v17, v17
    v_lshlrev_b32 v18, 2, v2
    v_mov_b32 v19, 0
    v_mov_b32 v20, 1
    v_mul_f32 v60, v16, v17
    ds_write_b32 v18, v60 offset:256
    ds_write_b32 v19, v20 offset:200
    s_branch L_Aend
L_A3:
    s_mov_b32 s3, 4
    s_mov_b32 s64, 0
    s_mov_b32 s66, 0
    s_mov_b32 s68, 0
    s_mov_b32 s40, s8
    s_mov_b32 s41, s9
    s_mov_b32 s42, 1152
    s_mov_b32 s43, 0x20000
    s_branch L_T
L_B:
    s_sub_u32 s3, s3, 4
    s_mov_b32 s42, 1152
    s_mov_b32 s43, 0x20000
    v_lshlrev_b32 v3, 4, v0
    v_lshlrev_b32 v9, 2, v0
    v_add_u32 v9, 1024, v9
    s_mul_i32 s56, s6, 288
    v_lshlrev_b32 v10, 3, v0
    v_add_u32 v10, s56, v10
    s_mov_b32 s46, 9216
    s_mov_b32 s47, 0x20000
    s_mov_b32 s50, 9216
    s_mov_b32 s51, 0x20000
    s_mov_b32 s58, 9216
    s_mov_b32 s59, 0x20000
    s_setprio 3
    s_waitcnt lgkmcnt(0)
    s_add_u32 s30, s3, 4
    s_mov_b32 s68, 0
    s_mov_b32 s40, s8
    s_mov_b32 s41, s9
    buffer_load_dwordx4 v[4:7], v3, s[40:43], 0 offen
    buffer_load_dword v8, v9, s[40:43], 0 offen
    s_load_dword s34, s[32:33], 0
    s_mov_b32 s44, s20
    s_mov_b32 s45, s21
    s_mov_b32 s48, s22
    s_mov_b32 s49, s23
    s_mov_b32 s56, s24
    s_mov_b32 s57, s25
    s_mov_b32 exec_hi, 15
    buffer_load_dwordx2 v[40:41], v10, s[44:47], 0 offen
    buffer_load_dwordx2 v[42:43], v10, s[48:51], 0 offen
    buffer_load_dwordx2 v[44:45], v10, s[56:59], 0 offen
    s_mov_b64 exec, -1
    s_mov_b32 s36, s32
    s_mov_b32 s37, s33
    s_mov_b32 s38, 2097152
    s_mov_b32 s39, 0x20000
    v_mov_b32 v12, -1
    v_mov_b32 v13, -1
    v_mov_b32 v14, -1
    v_mov_b32 v15, -1
    s_cmp_lg_u32 s3, 0
    s_cbranch_scc1 L_B1
    s_lshl_b32 s56, s4, 13
    s_lshl_b32 s57, s5, 8
    s_add_u32 s56, s56, s57
    s_add_u32 s56, s56, 65536
    v_lshlrev_b32 v16, 12, v1
    v_lshl_add_u32 v16, v2, 4, v16
    v_add_u32 v16, s56, v16
    s_lshl_b32 s56, s4, 11
    s_lshl_b32 s57, s5, 6
    s_add_u32 s56, s56, s57
    s_add_u32 s56, s56, 458752
    v_lshlrev_b32 v17, 10, v0
    v_add_u32 v17, s56, v17
    s_mov_b32 exec_hi, 0
    s_mov_b32 s56, 458752
    buffer_store_dwordx4 v[12:15], v16, s[36:39], 0 offen sc1
    buffer_store_dwordx4 v[12:15], v16, s[36:39], s56 offen sc1
    s_mov_b64 exec, 3
    buffer_store_dwordx2 v[12:13], v17, s[36:39], 0 offen sc1
    s_mov_b64 exec, -1
L_B1:
    s_cmp_lg_u32 s3, 3
    s_cbranch_scc1 L_B2
    s_mul_i32 s60, s7, 10240
    s_lshl_b32 s61, s6, 6
    s_add_u32 s60, s60, s61
    v_lshrrev_b32 v16, 2, v0
    v_lshlrev_b32 v16, 11, v16
    v_and_b32 v17, 3, v0
    v_lshl_add_u32 v16, v17, 4, v16
    v_add_u32 v16, s60, v16
    s_mov_b32 s60, 196608
    s_mov_b32 s61, 327680
    s_mov_b32 exec_lo, 0xfffff
    s_mov_b32 exec_hi, 0
    buffer_store_dwordx4 v[12:15], v16, s[36:39], s60 offen sc1
    buffer_store_dwordx4 v[12:15], v16, s[36:39], s61 offen sc1
    s_mov_b64 exec, -1
L_B2:
    v_lshlrev_b32 v110, 10, v1
    v_bfe_u32 v111, v0, 2, 2
    v_lshl_add_u32 v110, v111, 7, v110
    v_and_b32 v111, 3, v0
    v_lshl_add_u32 v110, v111, 3, v110
    v_bfe_u32 v111, v0, 3, 1
    v_bfe_u32 v112, v0, 4, 1
    v_lshl_add_u32 v111, v112, 1, v111
    v_xor_b32 v111, s3, v111
    v_lshl_add_u32 v110, v111, 5, v110
    s_lshr_b32 s56, s5, 2
    s_mul_i32 s56, s56, 288
    v_lshlrev_b32 v111, 4, v1
    v_add_u32 v111, s56, v111
    s_lshl_b32 s56, s4, 13
    s_add_u32 s56, s56, 1048576
    s_lshr_b32 s57, s5, 2
    s_lshl_b32 s57, s57, 11
    s_add_u32 s57, s57, s56
    s_and_b32 s58, s5, 3
    s_lshl_b32 s58, s58, 9
    s_add_u32 s57, s57, s58
    s_lshl_b32 s58, s3, 7
    s_add_u32 s57, s57, s58
    v_lshlrev_b32 v112, 3, v2
    v_add_u32 v112, s57, v112
    s_lshl_b32 s57, s3, 9
    s_add_u32 s56, s56, s57
    v_lshlrev_b32 v90, 3, v0
    v_add_u32 v90, s56, v90
    s_mov_b32 s63, 4096
    v_mul_u32_u24 v114, 3641, v0
    v_lshrrev_b32 v114, 16, v114
    v_mul_u32_u24 v113, 18, v114
    v_sub_u32 v113, v0, v113
    s_mul_i32 s56, s7, 144
    s_mul_i32 s57, s3, 36
    s_add_u32 s56, s56, s57
    v_lshlrev_b32 v113, 1, v113
    v_add_u32 v113, s56, v113
    v_min_u32 v114, 2, v114
    v_mul_u32_u24 v115, 96, v114
    v_mul_u32_u24 v114, 384, v114
    s_mul_i32 s56, s3, 18
    v_add_u32 v116, s56, v0
    v_lshrrev_b32 v117, 4, v116
    v_lshlrev_b32 v117, 11, v117
    v_and_b32 v116, 15, v116
    v_lshl_add_u32 v116, v116, 2, v117
    s_mul_i32 s56, s7, 10240
    s_lshl_b32 s57, s6, 6
    s_add_u32 s56, s56, s57
    s_add_u32 s56, s56, 327680
    v_add_u32 v116, s56, v116
    s_mov_b32 s31, 99
    s_cmp_eq_u32 s6, 0
    s_cselect_b32 s31, s3, s31
    s_sub_u32 s56, s6, 1
    s_or_b32 s56, s56, s3
    s_cmp_eq_u32 s56, 0
    s_cselect_b32 s31, 4, s31
    s_min_u32 s57, s31, 4
    s_mul_i32 s56, s7, 144
    s_lshl_b32 s58, s57, 5
    s_add_u32 s56, s56, s58
    v_lshlrev_b32 v106, 1, v2
    v_add_u32 v106, s56, v106
    s_mul_i32 s56, s7, 5
    s_add_u32 s56, s56, s57
    s_lshl_b32 s56, s56, 11
    v_lshlrev_b32 v102, 2, v0
    v_add_u32 v102, s56, v102
    s_lshl_b32 s56, s7, 8
    s_add_u32 s56, s56, 24576
    v_and_b32 v107, 31, v0
    v_lshlrev_b32 v107, 3, v107
    v_add_u32 v107, s56, v107
    v_mov_b32 v108, 0
    s_mov_b32 s72, s26
    s_mov_b32 s73, s27
    s_mov_b32 s74, 2
    s_mov_b32 s75, 0x20000
    s_mov_b32 s76, s28
    s_mov_b32 s77, s29
    s_mov_b32 s78, 1152
    s_mov_b32 s79, 0x20000
    v_lshlrev_b32 v3, 4, v0
    v_lshlrev_b32 v9, 2, v0
    v_add_u32 v3, 320, v3
    v_add_u32 v9, 1344, v9
    v_cmp_gt_u32 s[60:61], 32, v0
    s_mov_b32 s62, 0
    s_waitcnt vmcnt(3)
    v_lshlrev_b32 v16, 16, v4
    v_and_b32 v17, 0xffff0000, v4
    v_lshlrev_b32 v18, 16, v5
    v_and_b32 v19, 0xffff0000, v5
    v_lshlrev_b32 v20, 16, v6
    v_and_b32 v21, 0xffff0000, v6
    v_lshlrev_b32 v22, 16, v7
    v_and_b32 v23, 0xffff0000, v7
    v_lshlrev_b32 v24, 16, v8
    v_and_b32 v25, 0xffff0000, v8
    s_nop 1
LN_7:
    v_add_f32 v26, v16, v17
    v_add_f32 v27, v18, v19
    v_add_f32 v28, v20, v21
    v_add_f32 v29, v22, v23
    v_add_f32 v30, v24, v25
    v_add_f32 v26, v26, v27
    v_add_f32 v28, v28, v29
    v_add_f32 v26, v26, v30
    v_add_f32 v26, v26, v28
    s_nop 1
    v_add_f32_dpp v26, v26, v26 row_ror:8 row_mask:0xf bank_mask:0xf
    s_nop 1
    v_add_f32_dpp v26, v26, v26 row_ror:4 row_mask:0xf bank_mask:0xf
    s_nop 1
    v_add_f32_dpp v26, v26, v26 row_ror:2 row_mask:0xf bank_mask:0xf
    s_nop 1
    v_add_f32_dpp v26, v26, v26 row_ror:1 row_mask:0xf bank_mask:0xf
    v_mov_b32 v27, v26
    s_nop 1
    v_permlane16_swap_b32 v26, v27
    v_add_f32 v26, v26, v27
    v_mov_b32 v27, v26
    s_nop 1
    v_permlane32_swap_b32 v26, v27
    v_add_f32 v26, v26, v27
    v_mul_f32 v26, 0x3ae38e39, v26
    v_sub_f32 v28, v16, v26
    v_sub_f32 v29, v17, v26
    v_sub_f32 v30, v18, v26
    v_sub_f32 v31, v19, v26
    v_sub_f32 v32, v20, v26
    v_sub_f32 v33, v21, v26
    v_sub_f32 v34, v22, v26
    v_sub_f32 v35, v23, v26
    v_sub_f32 v36, v24, v26
    v_sub_f32 v37, v25, v26
    v_cndmask_b32 v36, 0, v36, s[60:61]
    v_cndmask_b32 v37, 0, v37, s[60:61]
    v_mul_f32 v27, v28, v28
    v_mul_f32 v38, v29, v29
    v_fmac_f32 v27, v30, v30
    v_fmac_f32 v38, v31, v31
    v_fmac_f32 v27, v32, v32
    v_fmac_f32 v38, v33, v33
    v_fmac_f32 v27, v34, v34
    v_fmac_f32 v38, v35, v35
    v_fmac_f32 v27, v36, v36
    v_fmac_f32 v38, v37, v37
    v_add_f32 v27, v27, v38
    s_nop 1
    v_add_f32_dpp v27, v27, v27 row_ror:8 row_mask:0xf bank_mask:0xf
    s_nop 1
    v_add_f32_dpp v27, v27, v27 row_ror:4 row_mask:0xf bank_mask:0xf
    s_nop 1
    v_add_f32_dpp v27, v27, v27 row_ror:2 row_mask:0xf bank_mask:0xf
    s_nop 1
    v_add_f32_dpp v27, v27, v27 row_ror:1 row_mask:0xf bank_mask:0xf
    v_mov_b32 v28, v27
    s_nop 1
    v_permlane16_swap_b32 v27, v28
    v_add_f32 v27, v27, v28
    v_mov_b32 v28, v27
    s_nop 1
    v_permlane32_swap_b32 v27, v28
    v_add_f32 v27, v27, v28
    v_mul_f32 v27, 0x3ae38e39, v27
    v_cvt_pk_bf16_f32 v28, v26, v27
    v_lshlrev_b32 v26, 16, v28
    v_and_b32 v27, 0xffff0000, v28
    v_add_f32 v27, 0x3727c5ac, v27
    v_cvt_pk_bf16_f32 v27, v27, v27
    v_and_b32 v27, 0xffff0000, v27
    v_sqrt_f32 v27, v27
    v_sub_f32 v16, v16, v26
    v_sub_f32 v17, v17, v26
    v_sub_f32 v18, v18, v26
    v_sub_f32 v19, v19, v26
    v_sub_f32 v20, v20, v26
    v_sub_f32 v21, v21, v26
    v_sub_f32 v22, v22, v26
    v_sub_f32 v23, v23, v26
    v_sub_f32 v24, v24, v26
    v_sub_f32 v25, v25, v26
    v_cvt_pk_bf16_f32 v27, v27, v27
    v_and_b32 v27, 0xffff0000, v27
    v_rcp_f32 v28, v27
    v_cvt_pk_bf16_f32 v29, v16, v17
    v_cvt_pk_bf16_f32 v30, v18, v19
    v_cvt_pk_bf16_f32 v31, v20, v21
    v_cvt_pk_bf16_f32 v32, v22, v23
    v_cvt_pk_bf16_f32 v33, v24, v25
    v_lshlrev_b32 v16, 16, v29
    v_and_b32 v17, 0xffff0000, v29
    v_lshlrev_b32 v18, 16, v30
    v_and_b32 v19, 0xffff0000, v30
    v_lshlrev_b32 v20, 16, v31
    v_and_b32 v21, 0xffff0000, v31
    v_lshlrev_b32 v22, 16, v32
    v_and_b32 v23, 0xffff0000, v32
    v_lshlrev_b32 v24, 16, v33
    v_and_b32 v25, 0xffff0000, v33
    v_mul_f32 v29, v16, v28
    v_mul_f32 v30, v17, v28
    v_mul_f32 v31, v18, v28
    v_mul_f32 v32, v19, v28
    v_mul_f32 v33, v20, v28
    v_mul_f32 v34, v21, v28
    v_mul_f32 v35, v22, v28
    v_mul_f32 v36, v23, v28
    v_mul_f32 v37, v24, v28
    v_mul_f32 v38, v25, v28
    v_fma_f32 v16, -v29, v27, v16
    v_fma_f32 v17, -v30, v27, v17
    v_fma_f32 v18, -v31, v27, v18
    v_fma_f32 v19, -v32, v27, v19
    v_fma_f32 v20, -v33, v27, v20
    v_fma_f32 v21, -v34, v27, v21
    v_fma_f32 v22, -v35, v27, v22
    v_fma_f32 v23, -v36, v27, v23
    v_fma_f32 v24, -v37, v27, v24
    v_fma_f32 v25, -v38, v27, v25
    v_fma_f32 v16, v16, v28, v29
    v_fma_f32 v17, v17, v28, v30
    v_fma_f32 v18, v18, v28, v31
    v_fma_f32 v19, v19, v28, v32
    v_fma_f32 v20, v20, v28, v33
    v_fma_f32 v21, v21, v28, v34
    v_fma_f32 v22, v22, v28, v35
    v_fma_f32 v23, v23, v28, v36
    v_fma_f32 v24, v24, v28, v37
    v_fma_f32 v25, v25, v28, v38
    v_cvt_pk_bf16_f32 v4, v16, v17
    v_cvt_pk_bf16_f32 v5, v18, v19
    v_cvt_pk_bf16_f32 v6, v20, v21
    v_cvt_pk_bf16_f32 v7, v22, v23
    v_cvt_pk_bf16_f32 v8, v24, v25
    ds_write_b128 v3, v[4:7]
    ds_write_b32 v9, v8
    s_cmp_eq_u32 s62, 1
    s_cbranch_scc1 L_G
    s_waitcnt lgkmcnt(0)
    ds_read_b128 v[48:51], v111 offset:320
    ds_read_b128 v[52:55], v111 offset:384
    ds_read_b128 v[56:59], v111 offset:448
    ds_read_b128 v[60:63], v111 offset:512
    ds_read_b128 v[64:67], v111 offset:576
    s_add_u32 s34, s34, 2654435769
    v_mov_b32 v118, 0
    s_mov_b32 s35, 0
    s_nop 0
SP_8:
    ds_read_b128 v[120:123], v118 offset:224
    s_add_u32 s35, s35, 1
    s_cmp_gt_u32 s35, 1048576
    s_cbranch_scc1 L_end
    s_waitcnt lgkmcnt(0)
    v_and_b32 v120, v120, v121
    v_and_b32 v122, v122, v123
    v_and_b32 v120, v120, v122
    v_cmp_ne_u32 vcc, 1, v120
    s_cbranch_vccnz SP_8
    ds_read_b64_tr_b16 v[68:69], v110 offset:15360
    ds_read_b64_tr_b16 v[70:71], v110 offset:15872
    ds_read_b64_tr_b16 v[72:73], v110 offset:19456
    ds_read_b64_tr_b16 v[74:75], v110 offset:19968
    ds_read_b64_tr_b16 v[76:77], v110 offset:23552
    ds_read_b64_tr_b16 v[78:79], v110 offset:24064
    ds_read_b64_tr_b16 v[80:81], v110 offset:27648
    ds_read_b64_tr_b16 v[82:83], v110 offset:28160
    ds_read_b64_tr_b16 v[84:85], v110 offset:31744
    ds_read_b64_tr_b16 v[86:87], v110 offset:32256
    v_lshlrev_b32 v16, 16, v4
    v_and_b32 v17, 0xffff0000, v4
    v_lshlrev_b32 v18, 16, v5
    v_and_b32 v19, 0xffff0000, v5
    v_lshlrev_b32 v20, 16, v6
    v_and_b32 v21, 0xffff0000, v6
    v_lshlrev_b32 v22, 16, v7
    v_and_b32 v23, 0xffff0000, v7
    v_lshlrev_b32 v24, 16, v8
    v_and_b32 v25, 0xffff0000, v8
    v_cndmask_b32 v24, 0, v24, s[60:61]
    v_cndmask_b32 v25, 0, v25, s[60:61]
    v_add_u32 v3, 1280, v3
    v_add_u32 v9, 1280, v9
    v_mov_b32 v121, s34
    s_waitcnt lgkmcnt(8)
    v_mfma_f32_16x16x32_bf16 v[124:127], v[48:51], v[68:71], 0
    s_waitcnt lgkmcnt(6)
    v_mfma_f32_16x16x32_bf16 v[124:127], v[52:55], v[72:75], v[124:127]
    s_waitcnt lgkmcnt(4)
    v_mfma_f32_16x16x32_bf16 v[124:127], v[56:59], v[76:79], v[124:127]
    s_waitcnt lgkmcnt(2)
    v_mfma_f32_16x16x32_bf16 v[124:127], v[60:63], v[80:83], v[124:127]
    s_waitcnt lgkmcnt(0)
    v_mfma_f32_16x16x32_bf16 v[124:127], v[64:67], v[84:87], v[124:127]
    s_waitcnt vmcnt(0)
    s_nop 6
    v_mov_b32 v120, v124
    s_mov_b32 exec_lo, 0xffff
    s_mov_b32 exec_hi, 0
    buffer_store_dwordx2 v[120:121], v112, s[36:39], 0 offen sc1
    s_mov_b64 exec, -1
    s_lshl_b32 s56, s3, 2
    v_mov_b32 v118, s56
    v_mov_b32 v119, 1
    ds_write_b32 v118, v119 offset:176
    s_cmp_lg_u32 s3, 3
    s_cbranch_scc1 L_B3
    s_lshl_b32 s56, s7, 8
    s_lshl_b32 s57, s6, 3
    s_add_u32 s56, s56, s57
    s_add_u32 s56, s56, 24576
    v_mov_b32 v10, s56
    v_mov_b32 v12, s34
    v_not_b32 v13, v12
    s_mov_b64 exec, 1
    buffer_store_dwordx2 v[12:13], v10, s[36:39], 0 offen sc1
    s_mov_b64 exec, -1
    v_mov_b32 v118, 0
    ds_write_b32 v118, v119 offset:16
L_B3:
    v_lshlrev_b32 v48, 16, v40
    v_and_b32 v49, 0xffff0000, v40
    v_lshlrev_b32 v50, 16, v42
    v_and_b32 v51, 0xffff0000, v42
    v_lshlrev_b32 v52, 16, v41
    v_and_b32 v53, 0xffff0000, v41
    v_lshlrev_b32 v54, 16, v43
    v_and_b32 v55, 0xffff0000, v43
    v_lshlrev_b32 v10, 5, v0
    v_lshlrev_b32 v11, 3, v0
    s_mov_b32 exec_hi, 15
    ds_write_b128 v10, v[48:51] offset:12864
    ds_write_b128 v10, v[52:55] offset:12880
    ds_write_b64 v11, v[44:45] offset:14016
    s_mov_b64 exec, -1
    s_mov_b32 s62, 1
    s_branch LN_7
L_G:
    v_mov_b32 v15, v114
    v_mov_b32 v16, v115
    v_mov_b32 v20, 0xc0135761
    v_mov_b32 v21, v20
    v_mov_b32 v22, 0xbdd2d3e8
    v_mov_b32 v23, v22
    v_mov_b32 v24, 1.0
    v_mov_b32 v25, 1.0
    v_mov_b32 v26, 0
    s_waitcnt lgkmcnt(0)
    ds_read_u16 v18, v113 offset:1600
    s_waitcnt lgkmcnt(0)
    v_lshlrev_b32 v18, 16, v18
    v_mov_b32 v19, v18
    s_mov_b32 s56, 0
    s_nop 0
GL_9:
    s_cmp_lg_u32 s56, 3
    s_cbranch_scc1 NQ_10
    buffer_load_dwordx2 v[92:93], v90, s[36:39], 0 offen offset:0 sc1
    buffer_load_dwordx2 v[94:95], v90, s[36:39], 0 offen offset:2048 sc1
    buffer_load_dwordx2 v[96:97], v90, s[36:39], s63 offen offset:0 sc1
    buffer_load_dwordx2 v[98:99], v90, s[36:39], s63 offen offset:2048 sc1
    s_cmp_gt_u32 s31, 4
    s_cbranch_scc1 NQ_10
    buffer_load_dwordx2 v[124:125], v107, s[36:39], 0 offen sc1
    buffer_load_ushort v122, v106, s[40:43], 0 offen
    buffer_load_ushort v123, v108, s[72:75], 0 offen
NQ_10:
    ds_read_b128 v[44:47], v16 offset:14016
    ds_read_b128 v[28:31], v15 offset:12864
    ds_read_b128 v[32:35], v15 offset:12880
    ds_read_b128 v[36:39], v15 offset:12896
    ds_read_b128 v[40:43], v15 offset:12912
    v_add_u32 v15, 64, v15
    v_add_u32 v16, 16, v16
    s_waitcnt lgkmcnt(0)
    v_pk_mul_f32 v[48:49], v[18:19], v[28:29]
    v_pk_mul_f32 v[54:55], v[18:19], v[32:33]
    v_pk_mul_f32 v[60:61], v[18:19], v[36:37]
    v_pk_mul_f32 v[66:67], v[18:19], v[40:41]
    v_cvt_pk_bf16_f32 v50, v48, v49
    v_cvt_pk_bf16_f32 v56, v54, v55
    v_cvt_pk_bf16_f32 v62, v60, v61
    v_cvt_pk_bf16_f32 v68, v66, v67
    v_lshlrev_b32 v48, 16, v50
    v_and_b32 v49, 0xffff0000, v50
    v_lshlrev_b32 v54, 16, v56
    v_and_b32 v55, 0xffff0000, v56
    v_lshlrev_b32 v60, 16, v62
    v_and_b32 v61, 0xffff0000, v62
    v_lshlrev_b32 v66, 16, v68
    v_and_b32 v67, 0xffff0000, v68
    v_pk_add_f32 v[48:49], v[48:49], v[30:31]
    v_pk_add_f32 v[54:55], v[54:55], v[34:35]
    v_pk_add_f32 v[60:61], v[60:61], v[38:39]
    v_pk_add_f32 v[66:67], v[66:67], v[42:43]
    v_cvt_pk_bf16_f32 v50, v48, v49
    v_cvt_pk_bf16_f32 v56, v54, v55
    v_cvt_pk_bf16_f32 v62, v60, v61
    v_cvt_pk_bf16_f32 v68, v66, v67
    v_lshlrev_b32 v48, 16, v50
    v_and_b32 v49, 0xffff0000, v50
    v_lshlrev_b32 v54, 16, v56
    v_and_b32 v55, 0xffff0000, v56
    v_lshlrev_b32 v60, 16, v62
    v_and_b32 v61, 0xffff0000, v62
    v_lshlrev_b32 v66, 16, v68
    v_and_b32 v67, 0xffff0000, v68
    v_pk_mul_f32 v[50:51], v[48:49], v[48:49]
    v_pk_mul_f32 v[56:57], v[54:55], v[54:55]
    v_pk_mul_f32 v[62:63], v[60:61], v[60:61]
    v_pk_mul_f32 v[68:69], v[66:67], v[66:67]
    v_pk_fma_f32 v[50:51], v[50:51], v[22:23], v[20:21]
    v_pk_fma_f32 v[56:57], v[56:57], v[22:23], v[20:21]
    v_pk_fma_f32 v[62:63], v[62:63], v[22:23], v[20:21]
    v_pk_fma_f32 v[68:69], v[68:69], v[22:23], v[20:21]
    v_pk_mul_f32 v[50:51], v[50:51], v[48:49]
    v_pk_mul_f32 v[56:57], v[56:57], v[54:55]
    v_pk_mul_f32 v[62:63], v[62:63], v[60:61]
    v_pk_mul_f32 v[68:69], v[68:69], v[66:67]
    v_exp_f32 v50, v50
    v_exp_f32 v51, v51
    v_exp_f32 v56, v56
    v_exp_f32 v57, v57
    v_exp_f32 v62, v62
    v_exp_f32 v63, v63
    v_exp_f32 v68, v68
    v_exp_f32 v69, v69
    v_pk_add_f32 v[50:51], v[50:51], v[24:25]
    v_pk_add_f32 v[56:57], v[56:57], v[24:25]
    v_pk_add_f32 v[62:63], v[62:63], v[24:25]
    v_pk_add_f32 v[68:69], v[68:69], v[24:25]
    v_rcp_f32 v50, v50
    v_rcp_f32 v51, v51
    v_rcp_f32 v56, v56
    v_rcp_f32 v57, v57
    v_rcp_f32 v62, v62
    v_rcp_f32 v63, v63
    v_rcp_f32 v68, v68
    v_rcp_f32 v69, v69
    v_pk_mul_f32 v[50:51], v[50:51], v[48:49]
    v_pk_mul_f32 v[56:57], v[56:57], v[54:55]
    v_pk_mul_f32 v[62:63], v[62:63], v[60:61]
    v_pk_mul_f32 v[68:69], v[68:69], v[66:67]
    v_cvt_pk_bf16_f32 v52, v50, v51
    v_cvt_pk_bf16_f32 v58, v56, v57
    v_cvt_pk_bf16_f32 v64, v62, v63
    v_cvt_pk_bf16_f32 v70, v68, v69
    v_dot2c_f32_bf16 v26, v52, v44
    v_dot2c_f32_bf16 v26, v58, v45
    v_dot2c_f32_bf16 v26, v64, v46
    v_dot2c_f32_bf16 v26, v70, v47
    s_add_u32 s56, s56, 1
    s_cmp_lt_u32 s56, 6
    s_cbranch_scc1 GL_9
    s_lshl_b32 s56, s3, 8
    v_lshlrev_b32 v3, 2, v0
    v_add_u32 v3, s56, v3
    ds_write_b32 v3, v26 offset:14336
    s_waitcnt lgkmcnt(0)
    ds_read_b32 v27, v3 offset:14408
    ds_read_b32 v28, v3 offset:14480
    s_mov_b32 s35, 0
    s_branch QC_11
QP_12:
    buffer_load_dwordx2 v[92:93], v90, s[36:39], 0 offen offset:0 sc1
    buffer_load_dwordx2 v[94:95], v90, s[36:39], 0 offen offset:2048 sc1
    buffer_load_dwordx2 v[96:97], v90, s[36:39], s63 offen offset:0 sc1
    buffer_load_dwordx2 v[98:99], v90, s[36:39], s63 offen offset:2048 sc1
QC_11:
    s_add_u32 s35, s35, 1
    s_cmp_gt_u32 s35, 131072
    s_cbranch_scc1 L_end
    s_waitcnt vmcnt(0)
    v_min3_u32 v100, v93, v95, v97
    v_max3_u32 v101, v93, v95, v97
    v_min_u32 v100, v100, v99
    v_max_u32 v101, v101, v99
    v_cmp_ne_u32 vcc, s34, v100
    v_cmp_ne_u32 s[54:55], s34, v101
    s_nop 0
    s_or_b64 vcc, vcc, s[54:55]
    s_cbranch_vccnz QP_12
    s_nop 1
QO_13:
    v_add_f32 v92, v92, v94
    v_add_f32 v96, v96, v98
    v_add_f32 v92, v92, v96
    v_cvt_pk_bf16_f32 v92, v92, v92
    s_lshl_b32 s56, s3, 7
    v_lshlrev_b32 v100, 1, v0
    v_add_u32 v100, s56, v100
    s_lshl_b32 s56, s3, 2
    v_mov_b32 v101, s56
    v_mov_b32 v93, 1
    ds_write_b16 v100, v92 offset:2880
    ds_write_b32 v101, v93 offset:0
    s_waitcnt lgkmcnt(0)
    v_add_f32 v26, v26, v27
    v_add_f32 v26, v26, v28
    v_cmp_gt_u32 vcc, 18, v0
    s_nop 1
    v_cndmask_b32 v26, 0, v26, vcc
    v_min_u32 v26, -2, v26
    v_mov_b32 v3, 0
    s_mov_b32 s35, 0
    s_nop 0
SP_14:
    ds_read_b32 v9, v3 offset:16
    s_add_u32 s35, s35, 1
    s_cmp_gt_u32 s35, 1048576
    s_cbranch_scc1 L_end
    s_waitcnt lgkmcnt(0)
    v_cmp_ne_u32 vcc, 1, v9
    s_cbranch_vccnz SP_14
    s_cmp_eq_u32 s3, 3
    s_cselect_b32 s56, 26, 18
    v_cmp_gt_u32 vcc, s56, v0
    s_nop 0
    s_and_saveexec_b64 s[52:53], vcc
    buffer_store_dword v26, v116, s[36:39], 0 offen sc1
    s_mov_b64 exec, s[52:53]
    s_setprio 0
    s_cmp_gt_u32 s3, 1
    s_cbranch_scc1 ML_15
    v_mov_b32 v3, 0
    s_mov_b32 s35, 0
    s_nop 0
SP_16:
    ds_read_b128 v[16:19], v3 offset:32
    ds_read_b128 v[32:35], v3 offset:96
    ds_read_b128 v[20:23], v3 offset:48
    ds_read_b128 v[36:39], v3 offset:112
    ds_read_b128 v[24:27], v3 offset:64
    ds_read_b128 v[40:43], v3 offset:128
    ds_read_b128 v[28:31], v3 offset:80
    ds_read_b128 v[44:47], v3 offset:144
    s_add_u32 s35, s35, 1
    s_cmp_gt_u32 s35, 1048576
    s_cbranch_scc1 L_end
    s_waitcnt lgkmcnt(0)
    v_and_b32 v48, v34, v38
    v_and_b32 v49, v42, v46
    v_and_b32 v48, v48, v49
    v_cmp_ne_u32 vcc, 1, v48
    s_cbranch_vccnz SP_16
    s_cmp_eq_u32 s3, 0
    s_cselect_b64 vcc, -1, 0
    v_cndmask_b32 v16, v17, v16, vcc
    v_cndmask_b32 v20, v21, v20, vcc
    v_cndmask_b32 v24, v25, v24, vcc
    v_cndmask_b32 v28, v29, v28, vcc
    v_cndmask_b32 v32, v33, v32, vcc
    v_cndmask_b32 v36, v37, v36, vcc
    v_cndmask_b32 v40, v41, v40, vcc
    v_cndmask_b32 v44, v45, v44, vcc
    v_max3_f32 v50, v16, v20, v24
    v_max_f32 v50, v50, v28
    v_sub_f32 v16, v16, v50
    v_sub_f32 v20, v20, v50
    v_sub_f32 v24, v24, v50
    v_sub_f32 v28, v28, v50
    v_mul_f32 v16, 1069066811, v16
    v_mul_f32 v20, 1069066811, v20
    v_mul_f32 v24, 1069066811, v24
    v_mul_f32 v28, 1069066811, v28
    v_exp_f32 v16, v16
    v_exp_f32 v20, v20
    v_exp_f32 v24, v24
    v_exp_f32 v28, v28
    v_mul_f32 v51, v16, v32
    v_fmac_f32 v51, v20, v36
    v_fmac_f32 v51, v24, v40
    v_fmac_f32 v51, v28, v44
    v_min_u32 v50, -2, v50
    v_min_u32 v51, -2, v51
    s_lshl_b32 s56, s4, 1
    s_add_u32 s56, s56, s3
    s_lshl_b32 s56, s56, 10
    s_lshl_b32 s57, s5, 6
    s_add_u32 s56, s56, s57
    s_add_u32 s56, s56, 458752
    v_mov_b32 v52, s56
    s_mov_b64 exec, 1
    buffer_store_dwordx2 v[50:51], v52, s[36:39], 0 offen sc1
    s_mov_b64 exec, -1
ML_15:
    s_cmp_gt_u32 s31, 4
    s_cbranch_scc1 NF_17
    v_mov_b32 v12, s34
    v_not_b32 v12, v12
    s_mov_b32 s35, 0
    s_nop 0
    s_branch TC_18
TR_19:
    buffer_load_dwordx2 v[124:125], v107, s[36:39], 0 offen sc1
TC_18:
    s_add_u32 s35, s35, 1
    s_cmp_gt_u32 s35, 131072
    s_cbranch_scc1 L_end
    s_waitcnt vmcnt(0)
    v_cmp_ne_u32 vcc, s34, v124
    v_cmp_ne_u32 s[54:55], v12, v125
    s_nop 0
    s_or_b64 vcc, vcc, s[54:55]
    s_cbranch_vccnz TR_19
    v_lshlrev_b32 v122, 16, v122
    v_lshlrev_b32 v123, 16, v123
    s_nop 1
NF_17:
    s_cmp_gt_u32 s3, 1
    s_cbranch_scc1 W6_20
    s_branch L_T2
W6_20:
    s_mul_i32 s56, s6, 147456
    s_mul_i32 s57, s7, 144
    s_and_b32 s57, s57, 0xffffffc0
    s_add_u32 s56, s56, s57
    s_add_u32 s44, s16, s56
    s_addc_u32 s45, s17, 0
    s_mov_b32 s46, 146496
    s_mov_b32 s47, 0x20000
    s_sub_u32 s56, s3, 2
    s_lshl_b32 s57, s56, 4
    s_lshl_b32 s56, s56, 10
    s_add_u32 s56, s56, 35840
    s_mov_b32 s58, 21846
    v_lshrrev_b32 v12, 2, v0
    v_and_b32 v13, 3, v0
    v_lshlrev_b32 v13, 4, v13
    v_add_u32 v10, s57, v12
    v_mul_lo_u32 v11, v10, s58
    v_lshrrev_b32 v11, 16, v11
    v_mul_u32_u24 v11, 960, v11
    v_lshl_add_u32 v10, v10, 6, v13
    v_add_u32 v64, v10, v11
    s_add_u32 s57, s57, 32
    v_add_u32 v10, s57, v12
    v_mul_lo_u32 v11, v10, s58
    v_lshrrev_b32 v11, 16, v11
    v_mul_u32_u24 v11, 960, v11
    v_lshl_add_u32 v10, v10, 6, v13
    v_add_u32 v65, v10, v11
    s_add_u32 s57, s57, 32
    v_add_u32 v10, s57, v12
    v_mul_lo_u32 v11, v10, s58
    v_lshrrev_b32 v11, 16, v11
    v_mul_u32_u24 v11, 960, v11
    v_lshl_add_u32 v10, v10, 6, v13
    v_add_u32 v66, v10, v11
    s_add_u32 s57, s57, 32
    v_add_u32 v10, s57, v12
    v_mul_lo_u32 v11, v10, s58
    v_lshrrev_b32 v11, 16, v11
    v_mul_u32_u24 v11, 960, v11
    v_lshl_add_u32 v10, v10, 6, v13
    v_add_u32 v67, v10, v11
    s_add_u32 s57, s57, 32
    v_add_u32 v10, s57, v12
    v_mul_lo_u32 v11, v10, s58
    v_lshrrev_b32 v11, 16, v11
    v_mul_u32_u24 v11, 960, v11
    v_lshl_add_u32 v10, v10, 6, v13
    v_add_u32 v68, v10, v11
    s_add_u32 s57, s57, 32
    v_add_u32 v10, s57, v12
    v_mul_lo_u32 v11, v10, s58
    v_lshrrev_b32 v11, 16, v11
    v_mul_u32_u24 v11, 960, v11
    v_lshl_add_u32 v10, v10, 6, v13
    v_add_u32 v69, v10, v11
    s_add_u32 s57, s57, 32
    v_add_u32 v10, s57, v12
    v_mul_lo_u32 v11, v10, s58
    v_lshrrev_b32 v11, 16, v11
    v_mul_u32_u24 v11, 960, v11
    v_lshl_add_u32 v10, v10, 6, v13
    v_add_u32 v70, v10, v11
    s_add_u32 s57, s57, 32
    v_add_u32 v10, s57, v12
    v_mul_lo_u32 v11, v10, s58
    v_lshrrev_b32 v11, 16, v11
    v_mul_u32_u24 v11, 960, v11
    v_lshl_add_u32 v10, v10, 6, v13
    v_add_u32 v71, v10, v11
    s_add_u32 s57, s57, 32
    v_add_u32 v10, s57, v12
    v_mul_lo_u32 v11, v10, s58
    v_lshrrev_b32 v11, 16, v11
    v_mul_u32_u24 v11, 960, v11
    v_lshl_add_u32 v10, v10, 6, v13
    v_add_u32 v72, v10, v11
    s_add_u32 s57, s57, 32
    v_add_u32 v10, s57, v12
    v_mul_lo_u32 v11, v10, s58
    v_lshrrev_b32 v11, 16, v11
    v_mul_u32_u24 v11, 960, v11
    v_lshl_add_u32 v10, v10, 6, v13
    v_add_u32 v73, v10, v11
    s_add_u32 s57, s57, 32
    v_add_u32 v10, s57, v12
    v_mul_lo_u32 v11, v10, s58
    v_lshrrev_b32 v11, 16, v11
    v_mul_u32_u24 v11, 960, v11
    v_lshl_add_u32 v10, v10, 6, v13
    v_add_u32 v74, v10, v11
    s_add_u32 s57, s57, 32
    v_add_u32 v10, s57, v12
    v_mul_lo_u32 v11, v10, s58
    v_lshrrev_b32 v11, 16, v11
    v_mul_u32_u24 v11, 960, v11
    v_lshl_add_u32 v10, v10, 6, v13
    v_add_u32 v75, v10, v11
    v_mov_b32 v3, 0
    s_mov_b32 s35, 0
    s_nop 0
SP_21:
    ds_read_b128 v[16:19], v3 offset:160
    s_add_u32 s35, s35, 1
    s_cmp_gt_u32 s35, 1048576
    s_cbranch_scc1 L_end
    s_waitcnt lgkmcnt(0)
    v_and_b32 v16, v16, v17
    v_and_b32 v18, v18, v19
    v_and_b32 v16, v16, v18
    v_cmp_ne_u32 vcc, 1, v16
    s_cbranch_vccnz SP_21
    s_mov_b32 m0, s56
    s_nop 0
    buffer_load_dwordx4 v64, s[44:47], 0 offen nt lds
    s_add_u32 m0, m0, 2048
    s_nop 0
    buffer_load_dwordx4 v65, s[44:47], 0 offen nt lds
    s_add_u32 m0, m0, 2048
    s_nop 0
    buffer_load_dwordx4 v66, s[44:47], 0 offen nt lds
    s_add_u32 m0, m0, 2048
    s_nop 0
    buffer_load_dwordx4 v67, s[44:47], 0 offen nt lds
    s_add_u32 m0, m0, 2048
    s_nop 0
    buffer_load_dwordx4 v68, s[44:47], 0 offen nt lds
    s_add_u32 m0, m0, 2048
    s_nop 0
    buffer_load_dwordx4 v69, s[44:47], 0 offen nt lds
    s_add_u32 m0, m0, 2048
    s_nop 0
    buffer_load_dwordx4 v70, s[44:47], 0 offen nt lds
    s_add_u32 m0, m0, 2048
    s_nop 0
    buffer_load_dwordx4 v71, s[44:47], 0 offen nt lds
    s_add_u32 m0, m0, 2048
    s_nop 0
    buffer_load_dwordx4 v72, s[44:47], 0 offen nt lds
    s_add_u32 m0, m0, 2048
    s_nop 0
    buffer_load_dwordx4 v73, s[44:47], 0 offen nt lds
    s_add_u32 m0, m0, 2048
    s_nop 0
    buffer_load_dwordx4 v74, s[44:47], 0 offen nt lds
    s_add_u32 m0, m0, 2048
    s_nop 0
    buffer_load_dwordx4 v75, s[44:47], 0 offen nt lds
    s_lshl_b32 s56, s3, 2
    v_mov_b32 v15, s56
    v_mov_b32 v20, 1
    s_waitcnt vmcnt(4)
    ds_write_b32 v15, v20 offset:12
    s_branch L_T2
L_T:
    s_mov_b32 s31, 99
    v_mov_b32 v102, 0
    v_mov_b32 v106, 0
    s_mov_b32 s76, s28
    s_mov_b32 s77, s29
    s_mov_b32 s78, 1152
    s_mov_b32 s79, 0x20000
L_T2:
    s_lshl_b32 s56, s4, 1
    s_lshr_b32 s57, s5, 3
    s_add_u32 s56, s56, s57
    s_lshl_b32 s59, s56, 12
    v_lshlrev_b32 v10, 3, v1
    v_bfe_u32 v13, v0, 2, 2
    v_add_u32 v10, v10, v13
    v_mul_u32_u24 v10, 192, v10
    v_and_b32 v13, 3, v0
    v_lshl_add_u32 v10, v13, 3, v10
    s_lshl_b32 s56, s3, 5
    s_lshl_b32 s57, s7, 4
    s_and_b32 s57, s57, 63
    s_add_u32 s56, s56, s57
    v_add_u32 v10, s56, v10
    s_add_u32 s59, s59, 65536
    v_lshlrev_b32 v12, 4, v0
    s_mul_i32 s56, s7, 5
    s_add_u32 s56, s56, s3
    s_lshl_b32 s56, s56, 11
    s_lshl_b32 s57, s6, 6
    s_add_u32 s56, s56, s57
    s_add_u32 s56, s56, 196608
    v_bfe_u32 v13, v0, 2, 1
    v_bfe_u32 v14, v0, 3, 1
    v_lshl_add_u32 v13, v13, 1, v14
    v_lshl_add_u32 v13, v1, 2, v13
    v_lshlrev_b32 v13, 2, v13
    v_add_u32 v61, s56, v13
    v_lshlrev_b32 v66, 2, v2
    v_mov_b32 v3, 0
    v_and_b32 v23, 3, v0
    v_cmp_eq_u32 s[60:61], 0, v23
    v_add3_u32 v62, 0, v1, v2
    v_and_b32 v62, 15, v62
    v_lshlrev_b32 v62, 4, v62
    v_lshl_add_u32 v62, v1, 8, v62
    v_add3_u32 v63, 4, v1, v2
    v_and_b32 v63, 15, v63
    v_lshlrev_b32 v63, 4, v63
    v_lshl_add_u32 v63, v1, 8, v63
    v_add3_u32 v64, 8, v1, v2
    v_and_b32 v64, 15, v64
    v_lshlrev_b32 v64, 4, v64
    v_lshl_add_u32 v64, v1, 8, v64
    v_add3_u32 v65, 12, v1, v2
    v_and_b32 v65, 15, v65
    v_lshlrev_b32 v65, 4, v65
    v_lshl_add_u32 v65, v1, 8, v65
    s_cmp_ge_u32 s3, 4
    s_cbranch_scc1 NO_22
    s_lshl_b32 s56, s3, 2
    v_add3_u32 v14, s56, v1, v2
    v_and_b32 v14, 15, v14
    v_lshlrev_b32 v14, 4, v14
    v_lshl_add_u32 v14, v2, 8, v14
    s_lshl_b32 s56, s3, 10
    s_add_u32 s56, s56, s59
    v_add_u32 v13, s56, v12
    s_lshl_b32 s56, s3, 2
    v_mov_b32 v15, s56
    v_mov_b32 v20, 1
    v_mov_b32 v3, 0
    s_mov_b32 s35, 0
    s_nop 0
SP_24:
    ds_read_b128 v[16:19], v3 offset:16
    s_add_u32 s35, s35, 1
    s_cmp_gt_u32 s35, 1048576
    s_cbranch_scc1 L_end
    s_waitcnt lgkmcnt(0)
    v_and_b32 v17, v17, v18
    v_cmp_ne_u32 vcc, 1, v17
    s_cbranch_vccnz SP_24
    s_mov_b32 s57, 458752
    buffer_load_dwordx4 v[16:19], v13, s[36:39], s57 offen sc1
    buffer_load_dwordx4 v[76:79], v13, s[36:39], 0 offen sc1
    v_mov_b32 v22, 1
    s_cmp_lt_u32 s3, 2
    s_cbranch_scc1 OW_28
    s_waitcnt vmcnt(2)
    ds_write_b32 v15, v22 offset:184
OW_28:
    s_mov_b32 s35, 0
SP_29:
    ds_read_b64 v[20:21], v3 offset:192
    s_add_u32 s35, s35, 1
    s_cmp_gt_u32 s35, 1048576
    s_cbranch_scc1 L_end
    s_waitcnt lgkmcnt(0)
    v_and_b32 v20, v20, v21
    v_cmp_ne_u32 vcc, 1, v20
    s_cbranch_vccnz SP_29
    ds_read_b64_tr_b16 v[40:41], v10 offset:35840
    ds_read_b64_tr_b16 v[42:43], v10 offset:36608
    ds_read_b64_tr_b16 v[44:45], v10 offset:41984
    ds_read_b64_tr_b16 v[46:47], v10 offset:42752
    ds_read_b64_tr_b16 v[48:49], v10 offset:48128
    ds_read_b64_tr_b16 v[50:51], v10 offset:48896
    ds_read_b64_tr_b16 v[52:53], v10 offset:54272
    ds_read_b64_tr_b16 v[54:55], v10 offset:55040
    v_mov_b32 v20, 1
    s_mov_b32 s35, 0
    s_nop 0
    s_branch OC_26
OP_25:
    buffer_load_dwordx4 v[16:19], v13, s[36:39], s57 offen sc1
    s_waitcnt vmcnt(0)
    v_max3_u32 v21, v16, v17, v18
    v_max_u32 v21, v21, v19
    v_cmp_eq_u32 vcc, -1, v21
    s_cbranch_vccz OK_27
    buffer_load_dwordx4 v[16:19], v13, s[36:39], s57 offen sc1
    buffer_load_dwordx4 v[76:79], v13, s[36:39], 0 offen sc1
OC_26:
    s_add_u32 s35, s35, 1
    s_cmp_gt_u32 s35, 131072
    s_cbranch_scc1 L_end
    s_waitcnt vmcnt(1)
    v_max3_u32 v21, v16, v17, v18
    v_max_u32 v21, v21, v19
    v_cmp_eq_u32 vcc, -1, v21
    s_cbranch_vccz OK_27
    s_waitcnt vmcnt(0)
    v_max3_u32 v22, v76, v77, v78
    v_max_u32 v22, v22, v79
    v_cndmask_b32 v16, v16, v76, vcc
    v_cndmask_b32 v17, v17, v77, vcc
    v_cndmask_b32 v18, v18, v78, vcc
    v_cndmask_b32 v19, v19, v79, vcc
    v_cndmask_b32 v21, v21, v22, vcc
    v_cmp_eq_u32 vcc, -1, v21
    s_cbranch_vccnz OP_25
    s_nop 3
OK_27:
    ds_write_b128 v14, v[16:19] offset:8768
    ds_write_b32 v15, v20 offset:208
    s_cmp_gt_u32 s31, 4
    s_cbranch_scc1 L_T3
    s_mov_b32 s58, 327680
    buffer_load_dword v80, v102, s[36:39], s58 offen offset:0 sc1
    buffer_load_dword v81, v102, s[36:39], s58 offen offset:256 sc1
    buffer_load_dword v82, v102, s[36:39], s58 offen offset:512 sc1
    buffer_load_dword v83, v102, s[36:39], s58 offen offset:768 sc1
    buffer_load_dword v84, v102, s[36:39], s58 offen offset:1024 sc1
    buffer_load_dword v85, v102, s[36:39], s58 offen offset:1280 sc1
    buffer_load_dword v86, v102, s[36:39], s58 offen offset:1536 sc1
    buffer_load_dword v87, v102, s[36:39], s58 offen offset:1792 sc1
    s_branch L_T3
NO_22:
    s_mov_b32 s35, 0
SP_30:
    ds_read_b64 v[20:21], v3 offset:192
    s_add_u32 s35, s35, 1
    s_cmp_gt_u32 s35, 1048576
    s_cbranch_scc1 L_end
    s_waitcnt lgkmcnt(0)
    v_and_b32 v20, v20, v21
    v_cmp_ne_u32 vcc, 1, v20
    s_cbranch_vccnz SP_30
    ds_read_b64_tr_b16 v[40:41], v10 offset:35840
    ds_read_b64_tr_b16 v[42:43], v10 offset:36608
    ds_read_b64_tr_b16 v[44:45], v10 offset:41984
    ds_read_b64_tr_b16 v[46:47], v10 offset:42752
    ds_read_b64_tr_b16 v[48:49], v10 offset:48128
    ds_read_b64_tr_b16 v[50:51], v10 offset:48896
    ds_read_b64_tr_b16 v[52:53], v10 offset:54272
    ds_read_b64_tr_b16 v[54:55], v10 offset:55040
L_T3:
    s_mov_b32 s35, 0
SP_31:
    ds_read_b128 v[16:19], v3 offset:208
    ds_read_b32 v20, v3 offset:200
    ds_read_b128 v[24:27], v62 offset:8768
    ds_read_b128 v[28:31], v63 offset:9792
    ds_read_b128 v[32:35], v64 offset:10816
    ds_read_b128 v[36:39], v65 offset:11840
    ds_read_b32 v60, v66 offset:256
    s_add_u32 s35, s35, 1
    s_cmp_gt_u32 s35, 1048576
    s_cbranch_scc1 L_end
    s_waitcnt lgkmcnt(0)
    v_and_b32 v16, v16, v17
    v_and_b32 v18, v18, v19
    v_and_b32 v16, v16, v20
    v_and_b32 v16, v16, v18
    v_cmp_ne_u32 vcc, 1, v16
    s_cbranch_vccnz SP_31
    v_mfma_f32_16x16x32_bf16 v[56:59], v[40:43], v[24:27], 0
    v_mfma_f32_16x16x32_bf16 v[56:59], v[44:47], v[28:31], v[56:59]
    v_mfma_f32_16x16x32_bf16 v[56:59], v[48:51], v[32:35], v[56:59]
    v_mfma_f32_16x16x32_bf16 v[56:59], v[52:55], v[36:39], v[56:59]
    s_nop 7
    v_mul_f32 v16, v56, v60
    v_mul_f32 v17, v57, v60
    v_mul_f32 v18, v58, v60
    v_mul_f32 v19, v59, v60
    v_add_f32_dpp v20, v16, v16 row_ror:8 row_mask:0xf bank_mask:0x3
    v_add_f32_dpp v21, v18, v18 row_ror:8 row_mask:0xf bank_mask:0x3
    s_nop 0
    v_add_f32_dpp v20, v17, v17 row_ror:8 row_mask:0xf bank_mask:0xc
    v_add_f32_dpp v21, v19, v19 row_ror:8 row_mask:0xf bank_mask:0xc
    s_nop 0
    v_add_f32_dpp v22, v20, v20 row_shl:4 row_mask:0xf bank_mask:0x5
    s_nop 1
    v_add_f32_dpp v22, v21, v21 row_shr:4 row_mask:0xf bank_mask:0xa
    s_nop 1
    v_add_f32_dpp v22, v22, v22 quad_perm:[1,0,3,2] row_mask:0xf bank_mask:0xf
    s_nop 1
    v_add_f32_dpp v22, v22, v22 quad_perm:[2,3,0,1] row_mask:0xf bank_mask:0xf
    v_min_u32 v22, -2, v22
    s_and_saveexec_b64 s[52:53], s[60:61]
    buffer_store_dword v22, v61, s[36:39], 0 offen sc1
    s_mov_b64 exec, s[52:53]
    s_cmp_gt_u32 s31, 4
    s_cbranch_scc1 L_Bend
    s_mov_b32 s58, 196608
    s_mov_b32 s59, 327680
    buffer_load_dword v16, v102, s[36:39], s58 offen offset:0 sc1
    buffer_load_dword v17, v102, s[36:39], s58 offen offset:256 sc1
    buffer_load_dword v18, v102, s[36:39], s58 offen offset:512 sc1
    buffer_load_dword v19, v102, s[36:39], s58 offen offset:768 sc1
    buffer_load_dword v20, v102, s[36:39], s58 offen offset:1024 sc1
    buffer_load_dword v21, v102, s[36:39], s58 offen offset:1280 sc1
    buffer_load_dword v22, v102, s[36:39], s58 offen offset:1536 sc1
    buffer_load_dword v23, v102, s[36:39], s58 offen offset:1792 sc1
    s_waitcnt vmcnt(9)
    v_max3_u32 v88, v80, v81, v82
    v_max3_u32 v89, v83, v84, v85
    v_add_f32 v80, v80, v81
    v_add_f32 v82, v82, v83
    v_max3_u32 v88, v88, v86, v87
    v_add_f32 v84, v84, v85
    v_add_f32 v86, v86, v87
    v_max_u32 v88, v88, v89
    v_add_f32 v80, v80, v82
    v_add_f32 v84, v84, v86
    v_cmp_eq_u32 vcc, -1, v88
    v_add_f32 v103, v80, v84
    s_cbranch_vccz YO_34
    s_mov_b32 s35, 0
    s_nop 1
YR_33:
    buffer_load_dword v80, v102, s[36:39], s59 offen offset:0 sc1
    buffer_load_dword v81, v102, s[36:39], s59 offen offset:256 sc1
    buffer_load_dword v82, v102, s[36:39], s59 offen offset:512 sc1
    buffer_load_dword v83, v102, s[36:39], s59 offen offset:768 sc1
    buffer_load_dword v84, v102, s[36:39], s59 offen offset:1024 sc1
    buffer_load_dword v85, v102, s[36:39], s59 offen offset:1280 sc1
    buffer_load_dword v86, v102, s[36:39], s59 offen offset:1536 sc1
    buffer_load_dword v87, v102, s[36:39], s59 offen offset:1792 sc1
    s_add_u32 s35, s35, 1
    s_cmp_gt_u32 s35, 131072
    s_cbranch_scc1 L_end
    s_waitcnt vmcnt(0)
    v_max3_u32 v88, v80, v81, v82
    v_max3_u32 v89, v83, v84, v85
    v_add_f32 v80, v80, v81
    v_add_f32 v82, v82, v83
    v_max3_u32 v88, v88, v86, v87
    v_add_f32 v84, v84, v85
    v_add_f32 v86, v86, v87
    v_max_u32 v88, v88, v89
    v_add_f32 v80, v80, v82
    v_add_f32 v84, v84, v86
    v_cmp_eq_u32 vcc, -1, v88
    v_add_f32 v103, v80, v84
    s_cbranch_vccnz YR_33
    s_nop 2
YO_34:
    v_mov_b32 v88, v103
    s_nop 1
    v_permlane16_swap_b32 v103, v88
    v_add_f32 v103, v103, v88
    v_mov_b32 v88, v103
    s_nop 1
    v_permlane32_swap_b32 v103, v88
    v_add_f32 v103, v103, v88
    v_cvt_pk_bf16_f32 v103, v103, v103
    v_and_b32 v103, 0xffff0000, v103
    v_add_f32 v103, v103, v123
    v_cvt_pk_bf16_f32 v103, v103, v103
    v_and_b32 v103, 0xffff0000, v103
    v_mul_f32 v104, 0xbfb8aa3b, v103
    v_exp_f32 v104, v104
    s_nop 0
    v_add_f32 v104, 1.0, v104
    v_rcp_f32 v104, v104
    s_nop 0
    v_mul_f32 v103, v103, v104
    v_cvt_pk_bf16_f32 v103, v103, v103
    v_and_b32 v103, 0xffff0000, v103
    s_cmp_eq_u32 s31, 4
    s_cselect_b32 s56, 8, 16
    v_cmp_gt_u32 s[60:61], s56, v0
    s_mov_b32 s35, 0
    s_nop 3
SL_36:
    buffer_load_dword v128, v102, s[36:39], s58 offen offset:0 sc1
    buffer_load_dword v129, v102, s[36:39], s58 offen offset:256 sc1
    buffer_load_dword v130, v102, s[36:39], s58 offen offset:512 sc1
    buffer_load_dword v131, v102, s[36:39], s58 offen offset:768 sc1
    buffer_load_dword v132, v102, s[36:39], s58 offen offset:1024 sc1
    buffer_load_dword v133, v102, s[36:39], s58 offen offset:1280 sc1
    buffer_load_dword v134, v102, s[36:39], s58 offen offset:1536 sc1
    buffer_load_dword v135, v102, s[36:39], s58 offen offset:1792 sc1
    s_waitcnt vmcnt(8)
    v_max3_u32 v24, v16, v17, v18
    v_max3_u32 v25, v19, v20, v21
    v_add_f32 v16, v16, v17
    v_add_f32 v18, v18, v19
    v_max3_u32 v24, v24, v22, v23
    v_add_f32 v20, v20, v21
    v_add_f32 v22, v22, v23
    v_max_u32 v24, v24, v25
    v_add_f32 v16, v16, v18
    v_add_f32 v20, v20, v22
    v_cmp_eq_u32 vcc, -1, v24
    v_add_f32 v105, v16, v20
    s_cbranch_vccz SD_35
    buffer_load_dword v16, v102, s[36:39], s58 offen offset:0 sc1
    buffer_load_dword v17, v102, s[36:39], s58 offen offset:256 sc1
    buffer_load_dword v18, v102, s[36:39], s58 offen offset:512 sc1
    buffer_load_dword v19, v102, s[36:39], s58 offen offset:768 sc1
    buffer_load_dword v20, v102, s[36:39], s58 offen offset:1024 sc1
    buffer_load_dword v21, v102, s[36:39], s58 offen offset:1280 sc1
    buffer_load_dword v22, v102, s[36:39], s58 offen offset:1536 sc1
    buffer_load_dword v23, v102, s[36:39], s58 offen offset:1792 sc1
    s_add_u32 s35, s35, 1
    s_cmp_gt_u32 s35, 131072
    s_cbranch_scc1 L_end
    s_waitcnt vmcnt(8)
    v_max3_u32 v24, v128, v129, v130
    v_max3_u32 v25, v131, v132, v133
    v_add_f32 v128, v128, v129
    v_add_f32 v130, v130, v131
    v_max3_u32 v24, v24, v134, v135
    v_add_f32 v132, v132, v133
    v_add_f32 v134, v134, v135
    v_max_u32 v24, v24, v25
    v_add_f32 v128, v128, v130
    v_add_f32 v132, v132, v134
    v_cmp_eq_u32 vcc, -1, v24
    v_add_f32 v105, v128, v132
    s_cbranch_vccnz SL_36
    s_nop 2
SD_35:
    v_mov_b32 v24, v105
    s_nop 1
    v_permlane16_swap_b32 v105, v24
    v_add_f32 v105, v105, v24
    v_mov_b32 v24, v105
    s_nop 1
    v_permlane32_swap_b32 v105, v24
    v_add_f32 v105, v105, v24
    v_cvt_pk_bf16_f32 v105, v105, v105
    v_and_b32 v105, 0xffff0000, v105
    v_mul_f32 v105, v105, v103
    v_cvt_pk_bf16_f32 v105, v105, v105
    v_and_b32 v105, 0xffff0000, v105
    v_add_f32 v105, v105, v122
    v_cvt_pk_bf16_f32 v105, v105, v105
    s_and_saveexec_b64 s[52:53], s[60:61]
    buffer_store_short v105, v106, s[76:79], 0 offen
    s_mov_b64 exec, s[52:53]
    s_or_b32 s56, s7, s31
    s_cmp_lg_u32 s56, 0
    s_cbranch_scc1 L_Bend
    v_mov_b32 v3, 0
    v_mov_b32 v4, s34
    s_mov_b64 exec, 1
    buffer_store_dword v4, v3, s[36:39], 0 offen sc1
    s_mov_b64 exec, -1
L_Bend:
    s_endpgm
L_end:
    s_endpgm
.section .rodata,"a"
.p2align 6
.amdhsa_kernel recurrent_scan__sliding_block_cached__mixer_token_mlp__decode_kernel
  .amdhsa_next_free_vgpr 256
  .amdhsa_next_free_sgpr 102
  .amdhsa_accum_offset 256
  .amdhsa_group_segment_fixed_size 0
  .amdhsa_kernarg_size 104
  .amdhsa_user_sgpr_count 2
  .amdhsa_user_sgpr_kernarg_segment_ptr 1
  .amdhsa_system_sgpr_workgroup_id_x 1
.end_amdhsa_kernel
```
